```python
import torch

def _softmax(x, axis=-1):
    return torch.softmax(x, dim=axis)
def _gelu(x):
    return torch.nn.functional.gelu(x, approximate="tanh")
def _silu(x):
    return torch.nn.functional.silu(x)
def _sigmoid(x):
    return torch.sigmoid(x)
def _layernorm(x, axis=-1, eps=1e-5):
    m = x.mean(dim=axis, keepdim=True)
    v = x.var(dim=axis, keepdim=True, unbiased=False)
    return (x - m) / torch.sqrt(v + eps)
def _scatter_add(tgt, idx, src, axis=0):
    return tgt.clone().index_add_(axis, idx, src)
def _segment_sum(src, seg, n):
    out = torch.zeros((n,) + src.shape[1:], dtype=src.dtype)
    return out.index_add_(0, seg, src)
def _pad(x, pw):
    flat = tuple(v for pair in reversed(pw) for v in pair)
    return torch.nn.functional.pad(x, flat)

kernel_name = 'standalone__moe_arch_mod__prompt'

def setup_inputs():

    _w = (lambda a: (lambda t: t.to(torch.bfloat16) if t.is_floating_point() else t)(torch.as_tensor(a)))
    B, S, D, F, C = 1, 2048, 1024, 3584, 2
    return {
        "x": _w((lambda *s: torch.randn(*s, dtype=torch.bfloat16) * 0.1)(B, S, D)),
        "w_r": _w((lambda *s: torch.randn(*s, dtype=torch.bfloat16) * 0.1)(D)),
        "w_gate": _w((lambda *s: torch.randn(*s, dtype=torch.bfloat16) * 0.1)(D, F)),
        "w_up": _w((lambda *s: torch.randn(*s, dtype=torch.bfloat16) * 0.1)(D, F)),
        "w_down": _w((lambda *s: torch.randn(*s, dtype=torch.bfloat16) * 0.1)(F, D)),
    }

def reference(x, w_r, w_gate, w_up, w_down):
    B, S, D = x.shape
    C = 2
    r = x @ w_r
    idx = torch.argsort(-r, axis=-1)[:, :C]
    idx_e = (lambda x, n, axis: torch.repeat_interleave(x, n, dim=axis))(idx.reshape(B, C, 1), D, axis=2)
    x_sel = (lambda x, i, axis: torch.take_along_dim(x, i, dim=axis))(x, idx_e, axis=1)
    g = _silu(x_sel @ w_gate)
    u = x_sel @ w_up
    y = (g * u) @ w_down
    r_sel = _sigmoid((lambda x, i, axis: torch.take_along_dim(x, i, dim=axis))(r, idx, axis=1))
    y = y * r_sel.reshape(B, C, 1)
    b_off = (torch.arange(B) * S).reshape(B, 1)
    flat_idx = (idx + b_off).reshape(B * C)
    zero = (x * 0.0).reshape(B * S, D)
    upd = _scatter_add(zero, flat_idx, y.reshape(B * C, D), axis=0)
    return x + upd.reshape(B, S, D)
```

```asm
; @launch grid=(256,1,1) block=(320,1,1) lds=77824
.amdgcn_target "amdgcn-amd-amdhsa--gfx950"
.text
.globl standalone__moe_arch_mod__prompt_kernel
.p2align 8
.type standalone__moe_arch_mod__prompt_kernel,@function
standalone__moe_arch_mod__prompt_kernel:
    s_cmp_ge_u32 s2, 256
    s_cbranch_scc1 L_end
    s_load_dwordx16 s[4:19], s[0:1], 0
    v_lshrrev_b32 v1, 6, v0
    v_and_b32 v0, 63, v0
    v_readfirstlane_b32 s20, v1
    s_cmp_eq_u32 s20, 0
    s_cbranch_scc0 L_ffn0
    s_setprio 2
    v_lshlrev_b32 v3, 4, v0
    s_lshl_b32 s21, s2, 14
    s_add_u32 s21, s21, 4096
    v_add_u32 v1, s21, v3
    v_add_u32 v2, 0x2000, v1
    s_lshr_b32 s21, s2, 3
    s_cmp_lg_u32 s21, 29
    s_cbranch_scc1 L_nopf
    s_getpc_b64 s[30:31]
L_pcref:
    v_lshlrev_b32 v12, 7, v0
    v_min_u32 v12, L_codeend-L_pcref-4, v12
    global_load_dword v54, v12, s[30:31]
L_nopf:
    s_waitcnt lgkmcnt(0)
    global_load_dwordx4 v[4:7], v3, s[6:7]
    global_load_dwordx4 v[8:11], v3, s[6:7] offset:1024
    global_load_dwordx4 v[80:83], v1, s[4:5] offset:-4096 nt
    global_load_dwordx4 v[84:87], v1, s[4:5] offset:-3072 nt
    global_load_dwordx4 v[88:91], v1, s[4:5] offset:-2048 nt
    global_load_dwordx4 v[92:95], v1, s[4:5] offset:-1024 nt
    global_load_dwordx4 v[96:99], v1, s[4:5] offset:0 nt
    global_load_dwordx4 v[100:103], v1, s[4:5] offset:1024 nt
    global_load_dwordx4 v[104:107], v1, s[4:5] offset:2048 nt
    global_load_dwordx4 v[108:111], v1, s[4:5] offset:3072 nt
    global_load_dwordx4 v[112:115], v2, s[4:5] offset:-4096 nt
    global_load_dwordx4 v[116:119], v2, s[4:5] offset:-3072 nt
    global_load_dwordx4 v[120:123], v2, s[4:5] offset:-2048 nt
    global_load_dwordx4 v[124:127], v2, s[4:5] offset:-1024 nt
    global_load_dwordx4 v[128:131], v2, s[4:5] offset:0 nt
    global_load_dwordx4 v[132:135], v2, s[4:5] offset:1024 nt
    global_load_dwordx4 v[136:139], v2, s[4:5] offset:2048 nt
    global_load_dwordx4 v[140:143], v2, s[4:5] offset:3072 nt
    s_load_dword s22, s[18:19], 0
    s_branch L_front
L_ffn0:
    s_sub_u32 s21, s20, 1
    s_and_b32 s23, s2, 7
    s_lshr_b32 s24, s2, 3
    s_and_b32 s26, s24, 3
    v_lshrrev_b32 v13, 4, v0
    v_and_b32 v14, 15, v0
    v_and_b32 v15, 1, v13
    s_cmp_ge_u32 s2, 224
    s_cbranch_scc1 L_help0
    s_lshr_b32 s24, s24, 2
    s_mul_i32 s25, s23, 7
    s_add_u32 s25, s25, s24
    v_bfe_u32 v1, v0, 1, 3
    v_lshlrev_b32 v2, 2, v15
    v_xor_b32 v1, v1, v2
    s_lshl_b32 s27, s26, 8
    s_lshl_b32 s28, s21, 6
    s_add_u32 s27, s27, s28
    v_add_u32 v1, s27, v1
    s_lshl_b32 s35, s27, 1
    v_mul_u32_u24 v1, 7168, v1
    v_lshl_add_u32 v1, v13, 5, v1
    v_and_b32 v2, 1, v0
    v_lshl_add_u32 v1, v2, 4, v1
    s_lshl_b32 s27, s25, 7
    v_add_u32 v1, s27, v1
    s_lshl_b32 s28, s21, 14
    s_mov_b32 s42, 7340032
    s_mov_b32 s43, 0x20000
    s_mov_b32 s46, 7340032
    s_mov_b32 s47, 0x20000
    s_and_b32 s24, s25, 7
    s_waitcnt lgkmcnt(0)
    s_load_dword s22, s[18:19], 0
    s_mov_b32 s40, s8
    s_mov_b32 s41, s9
    s_mov_b32 s44, s10
    s_mov_b32 s45, s11
    s_add_u32 m0, s28, 0
    s_mov_b32 s29, 0
    buffer_load_dwordx4 v1, s[40:43], s29 offen nt lds
    s_add_u32 m0, s28, 1024
    s_mov_b32 s29, 0
    buffer_load_dwordx4 v1, s[44:47], s29 offen nt lds
    s_add_u32 m0, s28, 2048
    s_mov_b32 s29, 57344
    buffer_load_dwordx4 v1, s[40:43], s29 offen nt lds
    s_add_u32 m0, s28, 3072
    s_mov_b32 s29, 57344
    buffer_load_dwordx4 v1, s[44:47], s29 offen nt lds
    s_branch L_ffn
L_help0:
    s_cmp_gt_u32 s23, 4
    s_cselect_b32 s25, 1, 0
    s_sub_u32 s25, s23, s25
    s_lshl_b32 s25, s25, 3
    s_add_u32 s25, s25, 3
    v_and_b32 v16, 7, v0
    v_lshl_add_u32 v16, v13, 6, v16
    v_mul_u32_u24 v16, 7168, v16
    s_lshl_b32 s30, s25, 7
    v_add_u32 v16, s30, v16
    s_lshl_b32 s24, s26, 2
    s_add_u32 s24, s24, s21
    s_cmp_eq_u32 s24, 2
    s_cbranch_scc0 L_help
    s_lshl_b32 s30, s23, 10
    s_add_u32 s30, s30, 32768
    v_and_b32 v5, 31, v0
    v_lshl_add_u32 v5, v5, 4, s30
    s_lshl_b32 s30, s23, 7
    s_add_u32 s30, s30, 40960
    v_and_b32 v6, 0, v0
    v_lshl_add_u32 v6, v6, 7, s30
    s_waitcnt lgkmcnt(0)
    global_load_dword v115, v5, s[18:19]
    global_load_dword v115, v6, s[18:19] sc1
    s_branch L_help
L_front:
    v_bfe_u32 v12, v0, 3, 1
    v_bfe_u32 v13, v0, 4, 1
    v_lshlrev_b32 v12, 2, v12
    v_lshl_add_u32 v12, v13, 1, v12
    v_lshrrev_b32 v13, 5, v0
    v_add_u32 v12, v12, v13
    s_lshl_b32 s21, s2, 3
    s_sub_u32 s21, 2047, s21
    v_sub_u32 v12, s21, v12
    s_mov_b32 s23, 0xffff0000
    s_mul_i32 s30, s2, 32
    s_add_u32 s30, s30, 4096
    s_add_u32 s31, s30, 8
    s_lshl_b32 s54, s2, 7
    s_add_u32 s54, s54, 65536
    s_getreg_b32 s56, hwreg(HW_REG_XCC_ID, 0, 4)
    s_and_b32 s33, s56, 7
    s_lshl_b32 s33, s33, 13
    s_add_u32 s33, s33, 131072
    s_getreg_b32 s55, hwreg(HW_REG_HW_ID, 8, 1)
    s_lshl_b32 s55, s55, 6
    s_add_u32 s55, s55, s33
    s_add_u32 s55, s55, 7680
    s_and_b32 s35, s2, 7
    s_lshl_b32 s35, s35, 10
    s_add_u32 s35, s35, 32768
    s_lshr_b32 s36, s2, 3
    s_lshl_b32 s36, s36, 4
    s_add_u32 s36, s36, s35
    v_mov_b32 v13, s36
    s_mov_b32 s24, 0
    s_mov_b32 s25, 0x80000000
    s_movk_i32 s58, 0x207
    s_waitcnt lgkmcnt(0)
    s_add_u32 s22, s22, 2654435769
    s_or_b32 s22, s22, 1
    s_mov_b32 s27, s22
    s_xor_b32 s29, s22, s56
    v_mov_b32 v41, s27
    v_mov_b32 v43, s29
    s_and_b32 s21, s2, 7
    v_lshl_add_u32 v14, v0, 6, s33
    v_add_u32 v15, 4096, v14
    v_and_b32 v52, 31, v0
    v_lshlrev_b32 v52, 6, v52
    v_cmp_gt_u32 s[48:49], 32, v0
    s_lshl_b32 s37, s21, 7
    s_add_u32 s37, s37, 65536
    v_lshl_add_u32 v53, v0, 10, s37
    v_lshl_add_u32 v48, v0, 4, s35
    v_lshl_add_u32 v49, v0, 3, s21
    v_mul_u32_u24 v49, 32, v49
    v_add_u32 v49, 4096, v49
    s_lshl_b32 s37, s21, 4
    s_add_u32 s37, s37, 40960
    v_lshl_add_u32 v50, v0, 7, s37
    s_lshl_b32 s37, s21, 7
    s_add_u32 s37, s37, 40960
    v_lshl_add_u32 v51, v0, 4, s37
    s_lshl_b32 s38, 1, s21
    s_xor_b32 s38, s38, 0xff
    s_mov_b32 s39, 0
    s_waitcnt vmcnt(12)
    v_dot2_f32_bf16 v16, v80, v4, 0
    v_dot2_f32_bf16 v17, v88, v4, 0
    v_dot2_f32_bf16 v16, v81, v5, v16
    v_dot2_f32_bf16 v17, v89, v5, v17
    v_dot2_f32_bf16 v16, v82, v6, v16
    v_dot2_f32_bf16 v17, v90, v6, v17
    v_dot2_f32_bf16 v16, v83, v7, v16
    v_dot2_f32_bf16 v17, v91, v7, v17
    v_dot2_f32_bf16 v16, v84, v8, v16
    v_dot2_f32_bf16 v17, v92, v8, v17
    v_dot2_f32_bf16 v16, v85, v9, v16
    v_dot2_f32_bf16 v17, v93, v9, v17
    v_dot2_f32_bf16 v16, v86, v10, v16
    v_dot2_f32_bf16 v17, v94, v10, v17
    v_dot2_f32_bf16 v16, v87, v11, v16
    v_dot2_f32_bf16 v17, v95, v11, v17
    s_waitcnt vmcnt(8)
    v_dot2_f32_bf16 v18, v96, v4, 0
    v_dot2_f32_bf16 v19, v104, v4, 0
    v_dot2_f32_bf16 v18, v97, v5, v18
    v_dot2_f32_bf16 v19, v105, v5, v19
    v_dot2_f32_bf16 v18, v98, v6, v18
    v_dot2_f32_bf16 v19, v106, v6, v19
    v_dot2_f32_bf16 v18, v99, v7, v18
    v_dot2_f32_bf16 v19, v107, v7, v19
    v_dot2_f32_bf16 v18, v100, v8, v18
    v_dot2_f32_bf16 v19, v108, v8, v19
    v_dot2_f32_bf16 v18, v101, v9, v18
    v_dot2_f32_bf16 v19, v109, v9, v19
    v_dot2_f32_bf16 v18, v102, v10, v18
    v_dot2_f32_bf16 v19, v110, v10, v19
    v_dot2_f32_bf16 v18, v103, v11, v18
    v_dot2_f32_bf16 v19, v111, v11, v19
    s_waitcnt vmcnt(4)
    v_dot2_f32_bf16 v20, v112, v4, 0
    v_dot2_f32_bf16 v21, v120, v4, 0
    v_dot2_f32_bf16 v20, v113, v5, v20
    v_dot2_f32_bf16 v21, v121, v5, v21
    v_dot2_f32_bf16 v20, v114, v6, v20
    v_dot2_f32_bf16 v21, v122, v6, v21
    v_dot2_f32_bf16 v20, v115, v7, v20
    v_dot2_f32_bf16 v21, v123, v7, v21
    v_dot2_f32_bf16 v20, v116, v8, v20
    v_dot2_f32_bf16 v21, v124, v8, v21
    v_dot2_f32_bf16 v20, v117, v9, v20
    v_dot2_f32_bf16 v21, v125, v9, v21
    v_dot2_f32_bf16 v20, v118, v10, v20
    v_dot2_f32_bf16 v21, v126, v10, v21
    v_dot2_f32_bf16 v20, v119, v11, v20
    v_dot2_f32_bf16 v21, v127, v11, v21
    v_permlane32_swap_b32 v16, v17
    v_permlane32_swap_b32 v18, v19
    v_add_f32 v16, v16, v17
    v_permlane32_swap_b32 v20, v21
    v_add_f32 v18, v18, v19
    v_add_f32 v20, v20, v21
    s_waitcnt vmcnt(2)
    v_dot2_f32_bf16 v22, v128, v4, 0
    v_dot2_f32_bf16 v22, v129, v5, v22
    v_dot2_f32_bf16 v22, v130, v6, v22
    v_dot2_f32_bf16 v22, v131, v7, v22
    v_dot2_f32_bf16 v22, v132, v8, v22
    v_dot2_f32_bf16 v22, v133, v9, v22
    v_dot2_f32_bf16 v22, v134, v10, v22
    v_dot2_f32_bf16 v22, v135, v11, v22
    v_permlane16_swap_b32 v16, v18
    v_add_f32 v16, v16, v18
    s_waitcnt vmcnt(1)
    v_dot2_f32_bf16 v23, v136, v4, 0
    v_dot2_f32_bf16 v23, v137, v5, v23
    v_dot2_f32_bf16 v23, v138, v6, v23
    v_dot2_f32_bf16 v23, v139, v7, v23
    v_add_f32_dpp v24, v16, v16 row_ror:8 row_mask:0xf bank_mask:0x3
    s_waitcnt vmcnt(0)
    v_dot2_f32_bf16 v23, v140, v8, v23
    v_dot2_f32_bf16 v23, v141, v9, v23
    v_dot2_f32_bf16 v23, v142, v10, v23
    v_dot2_f32_bf16 v23, v143, v11, v23
    s_nop 2
    v_permlane32_swap_b32 v22, v23
    v_add_f32 v22, v22, v23
    s_nop 1
    v_permlane16_swap_b32 v20, v22
    v_add_f32 v20, v20, v22
    s_nop 1
    v_add_f32_dpp v24, v20, v20 row_ror:8 row_mask:0xf bank_mask:0xc
    s_nop 1
    v_add_f32_dpp v24, v24, v24 row_half_mirror row_mask:0xf bank_mask:0xf
    s_nop 1
    v_add_f32_dpp v24, v24, v24 quad_perm:[1,0,3,2] row_mask:0xf bank_mask:0xf
    s_nop 1
    v_add_f32_dpp v24, v24, v24 quad_perm:[2,3,0,1] row_mask:0xf bank_mask:0xf
    v_cvt_pk_bf16_f32 v26, v24, v24
    v_cmp_u_f32 vcc, v24, v24
    v_ashrrev_i32 v27, 31, v26
    v_or_b32 v27, 0x80000000, v27
    v_xor_b32 v27, v26, v27
    v_and_or_b32 v27, v27, s23, v12
    v_cndmask_b32 v27, v27, v12, vcc
    v_cmp_class_f32 s[52:53], v24, s58
    s_nop 0
    v_max_u32_dpp v28, v27, v27 row_ror:8 row_mask:0xf bank_mask:0xf
    v_min_u32_dpp v29, v27, v27 row_ror:8 row_mask:0xf bank_mask:0xf
    s_nop 0
    v_max_u32_dpp v30, v28, v28 row_bcast:15 row_mask:0xa bank_mask:0xf
    v_min_u32_dpp v31, v28, v28 row_bcast:15 row_mask:0xa bank_mask:0xf
    v_max_u32_dpp v32, v29, v29 row_bcast:15 row_mask:0xa bank_mask:0xf
    v_max_u32 v29, v31, v32
    v_max_u32_dpp v40, v30, v30 row_bcast:31 row_mask:0xc bank_mask:0xf
    v_min_u32_dpp v31, v30, v30 row_bcast:31 row_mask:0xc bank_mask:0xf
    v_max_u32_dpp v32, v29, v29 row_bcast:31 row_mask:0xc bank_mask:0xf
    v_max_u32 v42, v31, v32
    s_mov_b64 exec, s[24:25]
    global_store_dwordx4 v13, v[40:43], s[18:19]
    s_barrier
    s_mov_b64 exec, -1
    v_readlane_b32 s26, v40, 63
    v_readlane_b32 s28, v42, 63
    s_atomic_swap_x2 s[26:27], s[18:19], s30
    s_atomic_swap_x2 s[28:29], s[18:19], s31
    s_sub_u32 s21, s2, 224
    s_cmp_lt_u32 s21, 8
    s_cbranch_scc1 L_gather
    s_barrier
    s_barrier
    s_load_dwordx4 s[44:47], s[18:19], s55
    s_mov_b32 s21, 65536
    s_branch L_fchk
L_fpoll:
    s_sleep 8
    s_load_dwordx4 s[44:47], s[18:19], s54 glc
    s_sub_u32 s21, s21, 1
    s_cbranch_scc1 L_end
L_fchk:
    s_waitcnt lgkmcnt(0)
    s_cmp_lg_u32 s45, s22
    s_cbranch_scc1 L_fpoll
    s_xor_b32 s47, s47, s22
    s_cmp_gt_u32 s47, 3
    s_cbranch_scc1 L_fpoll
L_fcopy:
    s_andn2_b32 s38, 0x7ff, s44
    s_andn2_b32 s39, 0x7ff, s46
    s_cmp_lg_u64 s[52:53], 0
    s_cbranch_scc1 L_fix
    s_lshl_b32 s36, s2, 3
    s_sub_u32 s38, s38, s36
    s_sub_u32 s39, s39, s36
    s_min_u32 s38, s38, 31
    s_min_u32 s39, s39, 31
    s_movk_i32 s37, 0xff
    s_bitset0_b32 s37, s38
    s_bitset0_b32 s37, s39
    s_bitcmp1_b32 s37, 0
    s_cbranch_scc0 L_skipl0
    global_store_dwordx4 v1, v[80:83], s[14:15] offset:-4096 sc0 sc1
    global_store_dwordx4 v1, v[84:87], s[14:15] offset:-3072 sc0 sc1
L_skipl0:
    s_bitcmp1_b32 s37, 1
    s_cbranch_scc0 L_skipl1
    global_store_dwordx4 v1, v[88:91], s[14:15] offset:-2048 sc0 sc1
    global_store_dwordx4 v1, v[92:95], s[14:15] offset:-1024 sc0 sc1
L_skipl1:
    s_bitcmp1_b32 s37, 2
    s_cbranch_scc0 L_skipl2
    global_store_dwordx4 v1, v[96:99], s[14:15] offset:0 sc0 sc1
    global_store_dwordx4 v1, v[100:103], s[14:15] offset:1024 sc0 sc1
L_skipl2:
    s_bitcmp1_b32 s37, 3
    s_cbranch_scc0 L_skipl3
    global_store_dwordx4 v1, v[104:107], s[14:15] offset:2048 sc0 sc1
    global_store_dwordx4 v1, v[108:111], s[14:15] offset:3072 sc0 sc1
L_skipl3:
    s_bitcmp1_b32 s37, 4
    s_cbranch_scc0 L_skipl4
    global_store_dwordx4 v2, v[112:115], s[14:15] offset:-4096 sc0 sc1
    global_store_dwordx4 v2, v[116:119], s[14:15] offset:-3072 sc0 sc1
L_skipl4:
    s_bitcmp1_b32 s37, 5
    s_cbranch_scc0 L_skipl5
    global_store_dwordx4 v2, v[120:123], s[14:15] offset:-2048 sc0 sc1
    global_store_dwordx4 v2, v[124:127], s[14:15] offset:-1024 sc0 sc1
L_skipl5:
    s_bitcmp1_b32 s37, 6
    s_cbranch_scc0 L_skipl6
    global_store_dwordx4 v2, v[128:131], s[14:15] offset:0 sc0 sc1
    global_store_dwordx4 v2, v[132:135], s[14:15] offset:1024 sc0 sc1
L_skipl6:
    s_bitcmp1_b32 s37, 7
    s_cbranch_scc0 L_skipl7
    global_store_dwordx4 v2, v[136:139], s[14:15] offset:2048 sc0 sc1
    global_store_dwordx4 v2, v[140:143], s[14:15] offset:3072 sc0 sc1
L_skipl7:
    s_endpgm
L_fix:
    s_lshl_b32 s37, s2, 3
    s_mov_b32 s40, 0
    s_mov_b32 s41, 0x7fff
    s_mov_b32 s42, 0x7f80
    v_subrev_u32 v1, 4096, v1
L_fix1:
    s_lshr_b32 s43, s40, 1
    s_add_u32 s43, s43, s37
    s_cmp_eq_u32 s43, s38
    s_cbranch_scc1 L_fix2
    s_cmp_eq_u32 s43, s39
    s_cbranch_scc1 L_fix2
    global_load_dwordx4 v[4:7], v1, s[4:5]
    s_waitcnt vmcnt(0)
    v_and_b32 v8, s41, v4
    v_bfe_u32 v9, v4, 16, 15
    v_cmp_eq_u32 vcc, s42, v8
    v_cmp_eq_u32 s[46:47], s42, v9
    v_or_b32 v8, 64, v4
    s_nop 0
    v_cndmask_b32 v4, v4, v8, vcc
    v_or_b32 v8, 0x400000, v4
    v_cndmask_b32 v4, v4, v8, s[46:47]
    v_and_b32 v8, s41, v5
    v_bfe_u32 v9, v5, 16, 15
    v_cmp_eq_u32 vcc, s42, v8
    v_cmp_eq_u32 s[46:47], s42, v9
    v_or_b32 v8, 64, v5
    s_nop 0
    v_cndmask_b32 v5, v5, v8, vcc
    v_or_b32 v8, 0x400000, v5
    v_cndmask_b32 v5, v5, v8, s[46:47]
    v_and_b32 v8, s41, v6
    v_bfe_u32 v9, v6, 16, 15
    v_cmp_eq_u32 vcc, s42, v8
    v_cmp_eq_u32 s[46:47], s42, v9
    v_or_b32 v8, 64, v6
    s_nop 0
    v_cndmask_b32 v6, v6, v8, vcc
    v_or_b32 v8, 0x400000, v6
    v_cndmask_b32 v6, v6, v8, s[46:47]
    v_and_b32 v8, s41, v7
    v_bfe_u32 v9, v7, 16, 15
    v_cmp_eq_u32 vcc, s42, v8
    v_cmp_eq_u32 s[46:47], s42, v9
    v_or_b32 v8, 64, v7
    s_nop 0
    v_cndmask_b32 v7, v7, v8, vcc
    v_or_b32 v8, 0x400000, v7
    v_cndmask_b32 v7, v7, v8, s[46:47]
    global_store_dwordx4 v1, v[4:7], s[14:15]
    s_waitcnt vmcnt(0)
L_fix2:
    v_add_u32 v1, 1024, v1
    s_add_u32 s40, s40, 1
    s_cmp_lt_u32 s40, 16
    s_cbranch_scc1 L_fix1
    s_endpgm
L_gather:
    s_mov_b32 s21, 65536
    s_mov_b32 s40, 24
    s_mov_b32 exec_hi, 0
    s_branch L_poll1
L_poll1s:
    s_mov_b32 s40, -1
    v_mov_b32 v48, v49
L_poll1r:
L_poll1:
    global_load_dwordx4 v[44:47], v48, s[18:19] sc1
    s_sub_u32 s40, s40, 1
    s_cbranch_scc1 L_poll1s
    s_sub_u32 s21, s21, 1
    s_cbranch_scc1 L_end
    s_waitcnt vmcnt(0)
    v_xor_b32 v33, v47, v41
    v_xor_b32 v34, v45, v41
    v_and_or_b32 v33, v33, -16, v34
    v_cmp_ne_u32 vcc, 0, v33
    s_cbranch_vccnz L_poll1r
    v_cmp_ne_u32 vcc, v47, v43
    v_max_u32_dpp v28, v44, v44 quad_perm:[1,0,3,2] row_mask:0xf bank_mask:0xf
    v_min_u32_dpp v31, v44, v44 quad_perm:[1,0,3,2] row_mask:0xf bank_mask:0xf
    v_max_u32_dpp v32, v46, v46 quad_perm:[1,0,3,2] row_mask:0xf bank_mask:0xf
    v_max_u32 v29, v31, v32
    v_max_u32_dpp v30, v28, v28 quad_perm:[2,3,0,1] row_mask:0xf bank_mask:0xf
    v_min_u32_dpp v31, v28, v28 quad_perm:[2,3,0,1] row_mask:0xf bank_mask:0xf
    v_max_u32_dpp v32, v29, v29 quad_perm:[2,3,0,1] row_mask:0xf bank_mask:0xf
    v_max_u32 v29, v31, v32
    v_max_u32_dpp v28, v30, v30 row_half_mirror row_mask:0xf bank_mask:0xf
    v_min_u32_dpp v31, v30, v30 row_half_mirror row_mask:0xf bank_mask:0xf
    v_max_u32_dpp v32, v29, v29 row_half_mirror row_mask:0xf bank_mask:0xf
    v_max_u32 v29, v31, v32
    v_max_u32_dpp v30, v28, v28 row_mirror row_mask:0xf bank_mask:0xf
    v_min_u32_dpp v31, v28, v28 row_mirror row_mask:0xf bank_mask:0xf
    v_max_u32_dpp v32, v29, v29 row_mirror row_mask:0xf bank_mask:0xf
    v_max_u32 v29, v31, v32
    v_max_u32_dpp v33, v30, v30 row_bcast:15 row_mask:0xa bank_mask:0xf
    v_min_u32_dpp v31, v30, v30 row_bcast:15 row_mask:0xa bank_mask:0xf
    v_max_u32_dpp v32, v29, v29 row_bcast:15 row_mask:0xa bank_mask:0xf
    v_max_u32 v34, v31, v32
    s_cmp_lg_u64 vcc, 0
    v_readlane_b32 s44, v33, 31
    v_readlane_b32 s46, v34, 31
    s_cselect_b32 s47, 2, 0
    s_xor_b32 s47, s47, s22
    s_mov_b32 exec_lo, 0xff
    v_mov_b32 v44, s44
    v_mov_b32 v45, s22
    v_mov_b32 v46, s46
    v_mov_b32 v47, s47
    s_mov_b64 exec, s[38:39]
    global_store_dwordx4 v50, v[44:47], s[18:19] sc1
    s_branch L_poll3
L_poll3r:
    s_mov_b64 exec, s[38:39]
L_poll3:
    global_load_dwordx4 v[44:47], v51, s[18:19] sc1
    s_mov_b32 exec_lo, 0xff
    s_sub_u32 s21, s21, 1
    s_cbranch_scc1 L_end
    s_waitcnt vmcnt(0)
    v_xor_b32 v33, v47, v41
    v_xor_b32 v34, v45, v41
    v_and_or_b32 v33, v33, -3, v34
    v_cmp_ne_u32 vcc, 0, v33
    s_cbranch_vccnz L_poll3r
    v_cmp_ne_u32 vcc, v47, v41
    v_max_u32_dpp v28, v44, v44 quad_perm:[1,0,3,2] row_mask:0xf bank_mask:0xf
    v_min_u32_dpp v31, v44, v44 quad_perm:[1,0,3,2] row_mask:0xf bank_mask:0xf
    v_max_u32_dpp v32, v46, v46 quad_perm:[1,0,3,2] row_mask:0xf bank_mask:0xf
    v_max_u32 v29, v31, v32
    v_max_u32_dpp v30, v28, v28 quad_perm:[2,3,0,1] row_mask:0xf bank_mask:0xf
    v_min_u32_dpp v31, v28, v28 quad_perm:[2,3,0,1] row_mask:0xf bank_mask:0xf
    v_max_u32_dpp v32, v29, v29 quad_perm:[2,3,0,1] row_mask:0xf bank_mask:0xf
    v_max_u32 v29, v31, v32
    v_max_u32_dpp v33, v30, v30 row_half_mirror row_mask:0xf bank_mask:0xf
    v_min_u32_dpp v31, v30, v30 row_half_mirror row_mask:0xf bank_mask:0xf
    v_max_u32_dpp v32, v29, v29 row_half_mirror row_mask:0xf bank_mask:0xf
    v_max_u32 v34, v31, v32
    s_cmp_lg_u64 vcc, 0
    v_readlane_b32 s44, v33, 0
    v_readlane_b32 s46, v34, 0
    s_cselect_b32 s47, 2, 0
    s_xor_b32 s47, s47, s22
    s_mov_b64 exec, -1
    v_mov_b32 v40, s44
    v_mov_b32 v42, s46
    v_mov_b32 v43, s47
    global_store_dwordx4 v14, v[40:43], s[18:19]
    global_store_dwordx4 v15, v[40:43], s[18:19]
    v_cndmask_b32 v9, v42, v40, s[48:49]
    v_not_b32 v9, v9
    v_and_b32 v9, 0x7ff, v9
    v_lshl_add_u32 v9, v9, 11, v52
    global_load_dword v44, v9, s[4:5]
    s_barrier
    s_mov_b64 exec, s[48:49]
    global_store_dwordx4 v53, v[40:43], s[18:19] sc1
    s_mov_b64 exec, -1
    s_barrier
    s_barrier
    s_branch L_fcopy
L_ffn:
    s_cmp_eq_u32 s24, 3
    s_cselect_b32 s32, 1, 0
    s_lshl_b32 s27, s25, 13
    s_lshl_b32 s29, s26, 11
    s_add_u32 s27, s27, s29
    s_lshl_b32 s29, s21, 9
    s_add_u32 s27, s27, s29
    s_add_u32 s27, s27, 1048576
    v_lshrrev_b32 v5, 5, v0
    v_lshlrev_b32 v156, 5, v14
    v_lshl_add_u32 v156, v5, 4, v156
    v_lshl_add_u32 v156, v15, 3, v156
    v_add_u32 v156, s27, v156
    v_lshlrev_b32 v3, 8, v13
    v_lshl_add_u32 v3, v14, 3, v3
    v_add_u32 v3, s28, v3
    v_lshlrev_b32 v4, 7, v15
    v_xor_b32 v5, 0x80, v4
    v_add_u32 v4, v3, v4
    v_add_u32 v3, v3, v5
    v_lshlrev_b32 v5, 2, v13
    v_cmp_eq_u32 vcc, v5, v14
    v_add_u32 v5, 1, v5
    v_cmp_eq_u32 s[30:31], v5, v14
    v_cndmask_b32 v152, 0, -1, vcc
    s_lshl_b32 s29, s21, 10
    v_cndmask_b32 v153, 0, -1, s[30:31]
    s_add_u32 s29, s29, 73728
    v_lshl_add_u32 v164, v0, 4, s29
    v_lshlrev_b32 v165, 10, v13
    v_lshl_add_u32 v165, v14, 4, v165
    s_lshl_b32 s29, s21, 8
    s_add_u32 s29, s29, 73728
    v_add_u32 v165, s29, v165
    s_getreg_b32 s33, hwreg(HW_REG_XCC_ID, 0, 3)
    s_lshl_b32 s33, s33, 13
    s_getreg_b32 s34, hwreg(HW_REG_HW_ID, 8, 1)
    s_lshl_b32 s34, s34, 2
    s_add_u32 s34, s34, s21
    s_mul_i32 s34, s34, 960
    s_add_u32 s34, s34, s33
    s_add_u32 s34, s34, 131072
    s_lshl_b32 s3, s2, 7
    s_add_u32 s3, s3, 65536
    v_lshlrev_b32 v7, 5, v14
    v_lshl_add_u32 v7, v15, 4, v7
    s_lshl_b32 s27, s25, 13
    s_and_b32 s29, s21, 1
    s_lshl_b32 s29, s29, 12
    s_add_u32 s27, s27, s29
    s_lshl_b32 s29, s26, 10
    s_add_u32 s27, s27, s29
    s_lshr_b32 s29, s21, 1
    s_lshl_b32 s29, s29, 9
    s_add_u32 s27, s27, s29
    s_add_u32 s27, s27, 1572864
    v_add_u32 v7, s27, v7
    s_add_u32 s48, s18, s27
    s_addc_u32 s49, s19, 0
    v_lshlrev_b32 v2, 13, v13
    v_lshl_add_u32 v2, v14, 4, v2
    s_lshl_b32 s27, s25, 17
    s_lshl_b32 s29, s21, 15
    s_add_u32 s27, s27, s29
    s_lshl_b32 s29, s26, 9
    s_add_u32 s27, s27, s29
    s_add_u32 s27, s27, 4096
    v_add_u32 v2, s27, v2
    v_bfe_u32 v5, v0, 2, 1
    v_lshlrev_b32 v157, 11, v5
    v_lshl_add_u32 v157, v13, 7, v157
    v_and_b32 v6, 3, v0
    v_lshl_add_u32 v157, v6, 5, v157
    v_bfe_u32 v5, v0, 3, 1
    v_lshl_add_u32 v157, v5, 4, v157
    s_lshl_b32 s27, s25, 13
    s_lshl_b32 s30, s21, 9
    s_add_u32 s27, s27, s30
    s_add_u32 s27, s27, 1052672
    v_add_u32 v157, s27, v157
    s_lshl_b32 s27, s21, 11
    s_add_u32 s27, s27, 65536
    v_lshl_add_u32 v5, v0, 4, s27
    v_and_b32 v6, 31, v0
    s_lshl_b32 s27, s21, 9
    s_add_u32 s27, s27, 65536
    v_lshl_add_u32 v6, v6, 4, s27
    v_and_b32 v8, 1, v0
    v_lshlrev_b32 v8, 4, v8
    v_mov_b32 v9, 0xffff
    v_lshlrev_b32 v12, v8, v9
    v_bfe_u32 v159, v0, 1, 2
    v_cmp_eq_u32 vcc, 0, v159
    s_nop 1
    v_cndmask_b32 v8, 0, v12, vcc
    v_cmp_eq_u32 vcc, 1, v159
    s_nop 1
    v_cndmask_b32 v9, 0, v12, vcc
    v_cmp_eq_u32 vcc, 2, v159
    s_nop 1
    v_cndmask_b32 v10, 0, v12, vcc
    v_cmp_eq_u32 vcc, 3, v159
    s_nop 1
    v_cndmask_b32 v11, 0, v12, vcc
    s_and_b32 s27, s2, 7
    s_lshl_b32 s29, s27, 2
    s_lshr_b32 s29, 0x54673210, s29
    s_and_b32 s29, s29, 7
    s_mul_i32 s29, s29, 6
    s_add_u32 s27, s27, 3
    s_and_b32 s27, s27, 7
    s_lshr_b32 s23, s2, 5
    s_cmp_gt_u32 s23, s27
    s_subb_u32 s23, s23, 0
    s_add_u32 s23, s23, s29
    s_lshl_b32 s23, s23, 2
    s_add_u32 s23, s23, s26
    s_mul_i32 s23, s23, 1
    s_add_u32 s23, s23, s21
    s_cmp_ge_u32 s21, 1
    s_cselect_b32 s23, 0x1000, s23
    s_cmp_lg_u32 s32, 0
    s_cselect_b32 s23, 0x1000, s23
    v_lshrrev_b32 v154, 2, v0
    v_lshlrev_b32 v154, 13, v154
    v_and_b32 v159, 3, v0
    v_lshl_add_u32 v154, v159, 4, v154
    s_mul_i32 s27, s23, 64
    s_add_u32 s27, s27, 1572864
    v_add_u32 v154, s27, v154
    v_lshrrev_b32 v155, 5, v0
    v_lshl_add_u32 v155, v15, 1, v155
    v_lshl_add_u32 v155, v159, 2, v155
    s_and_b32 s27, s23, 63
    s_mul_i32 s27, s27, 32
    v_lshl_add_u32 v155, v155, 1, s27
    s_waitcnt lgkmcnt(0)
    s_add_u32 s22, s22, 2654435769
    v_mov_b32 v166, s22
    s_or_b32 s22, s22, 1
    v_mov_b32 v12, s22
    v_mov_b32 v163, s22
    s_load_dword s50, s[48:49], 0 glc
    s_load_dword s51, s[48:49], 64 glc
    s_load_dword s52, s[48:49], 128 glc
    s_load_dword s53, s[48:49], 192 glc
    s_load_dword s54, s[48:49], 256 glc
    s_load_dword s55, s[48:49], 320 glc
    s_load_dword s56, s[48:49], 384 glc
    s_load_dword s57, s[48:49], 448 glc
    s_barrier
    global_load_dword v158, v156, s[18:19]
    s_add_u32 m0, s28, 4096
    s_mov_b32 s29, 114688
    buffer_load_dwordx4 v1, s[40:43], s29 offen nt lds
    s_add_u32 m0, s28, 5120
    s_mov_b32 s29, 114688
    buffer_load_dwordx4 v1, s[44:47], s29 offen nt lds
    s_add_u32 m0, s28, 6144
    s_mov_b32 s29, 172032
    buffer_load_dwordx4 v1, s[40:43], s29 offen nt lds
    s_add_u32 m0, s28, 7168
    s_mov_b32 s29, 172032
    buffer_load_dwordx4 v1, s[44:47], s29 offen nt lds
    s_add_u32 m0, s28, 8192
    s_mov_b32 s29, 229376
    buffer_load_dwordx4 v1, s[40:43], s29 offen nt lds
    s_add_u32 m0, s28, 9216
    s_mov_b32 s29, 229376
    buffer_load_dwordx4 v1, s[44:47], s29 offen nt lds
    s_add_u32 m0, s28, 10240
    s_mov_b32 s29, 286720
    buffer_load_dwordx4 v1, s[40:43], s29 offen nt lds
    s_waitcnt vmcnt(11)
    s_add_u32 m0, s28, 11264
    s_mov_b32 s29, 286720
    buffer_load_dwordx4 v1, s[44:47], s29 offen nt lds
    s_waitcnt vmcnt(11)
    ds_read_b64_tr_b16 v[16:17], v4 offset:0
    ds_read_b64_tr_b16 v[18:19], v3 offset:0
    ds_read_b64_tr_b16 v[20:21], v4 offset:1024
    ds_read_b64_tr_b16 v[22:23], v3 offset:1024
    s_add_u32 m0, s28, 12288
    s_mov_b32 s29, 344064
    buffer_load_dwordx4 v1, s[40:43], s29 offen nt lds
    s_waitcnt vmcnt(11)
    s_add_u32 m0, s28, 13312
    s_mov_b32 s29, 344064
    buffer_load_dwordx4 v1, s[44:47], s29 offen nt lds
    s_waitcnt vmcnt(11)
    ds_read_b64_tr_b16 v[24:25], v4 offset:2048
    ds_read_b64_tr_b16 v[26:27], v3 offset:2048
    ds_read_b64_tr_b16 v[28:29], v4 offset:3072
    ds_read_b64_tr_b16 v[30:31], v3 offset:3072
    s_add_u32 m0, s28, 14336
    s_mov_b32 s29, 401408
    buffer_load_dwordx4 v1, s[40:43], s29 offen nt lds
    s_waitcnt vmcnt(11)
    s_add_u32 m0, s28, 15360
    s_mov_b32 s29, 401408
    buffer_load_dwordx4 v1, s[44:47], s29 offen nt lds
    s_mov_b32 s24, 15
    s_waitcnt vmcnt(10)
    ds_read_b64_tr_b16 v[32:33], v4 offset:4096
    ds_read_b64_tr_b16 v[34:35], v3 offset:4096
    ds_read_b64_tr_b16 v[36:37], v4 offset:5120
    ds_read_b64_tr_b16 v[38:39], v3 offset:5120
    s_waitcnt vmcnt(8)
    ds_read_b64_tr_b16 v[40:41], v4 offset:6144
    ds_read_b64_tr_b16 v[42:43], v3 offset:6144
    ds_read_b64_tr_b16 v[44:45], v4 offset:7168
    ds_read_b64_tr_b16 v[46:47], v3 offset:7168
    s_waitcnt vmcnt(6)
    ds_read_b64_tr_b16 v[48:49], v4 offset:8192
    ds_read_b64_tr_b16 v[50:51], v3 offset:8192
    ds_read_b64_tr_b16 v[52:53], v4 offset:9216
    ds_read_b64_tr_b16 v[54:55], v3 offset:9216
    s_cmp_eq_u32 s32, 0
    s_cbranch_scc0 L_c3
    global_load_dwordx4 v[80:83], v2, s[12:13] offset:-4096 nt
    global_load_dwordx4 v[84:87], v2, s[12:13] offset:-3840 nt
    global_load_dwordx4 v[88:91], v2, s[12:13] offset:-2048 nt
    global_load_dwordx4 v[92:95], v2, s[12:13] offset:-1792 nt
    global_load_dwordx4 v[96:99], v2, s[12:13] offset:0 nt
    global_load_dwordx4 v[100:103], v2, s[12:13] offset:256 nt
    global_load_dwordx4 v[104:107], v2, s[12:13] offset:2048 nt
    global_load_dwordx4 v[108:111], v2, s[12:13] offset:2304 nt
L_wdj:
L_mfast:
    s_sub_u32 s24, s24, 1
    s_cbranch_scc1 L_mslow
    s_load_dwordx4 s[28:31], s[18:19], s34
    s_add_u32 s34, s34, 64
    s_waitcnt lgkmcnt(0)
    s_cmp_eq_u32 s29, s22
    s_cbranch_scc0 L_mfr
    s_xor_b32 s33, s31, s22
    s_cmp_le_u32 s33, 3
    s_cbranch_scc0 L_mfr
L_mgot:
    s_andn2_b32 s29, 0x7ff, s28
    s_andn2_b32 s31, 0x7ff, s30
    s_lshl_b32 s29, s29, 11
    s_lshl_b32 s31, s31, 11
    s_add_u32 s26, s29, s35
    s_add_u32 s27, s31, s35
    s_load_dwordx16 s[36:51], s[4:5], s26
    s_load_dwordx16 s[68:83], s[4:5], s27
    s_add_u32 s26, s26, 64
    s_add_u32 s27, s27, 64
    s_load_dwordx16 s[52:67], s[4:5], s26
    s_load_dwordx16 s[84:99], s[4:5], s27
L_mhave:
    s_bitcmp1_b32 s23, 6
    s_cselect_b32 s28, s30, s28
    s_cselect_b32 s29, s31, s29
    v_add_u32 v155, s29, v155
    s_waitcnt lgkmcnt(0)
    v_and_b32 v112, s36, v152
    v_and_b32 v113, s37, v152
    v_and_b32 v114, s38, v152
    v_and_b32 v115, s39, v152
    v_and_or_b32 v112, v153, s68, v112
    v_and_or_b32 v113, v153, s69, v113
    v_and_or_b32 v114, v153, s70, v114
    v_and_or_b32 v115, v153, s71, v115
    v_and_b32 v116, s40, v152
    v_and_b32 v117, s41, v152
    v_and_b32 v118, s42, v152
    v_and_b32 v119, s43, v152
    v_and_or_b32 v116, v153, s72, v116
    v_and_or_b32 v117, v153, s73, v117
    v_and_or_b32 v118, v153, s74, v118
    v_and_or_b32 v119, v153, s75, v119
    v_mfma_f32_16x16x32_bf16 v[144:147], v[112:115], v[16:19], 0
    v_mfma_f32_16x16x32_bf16 v[148:151], v[112:115], v[20:23], 0
    v_and_b32 v112, s44, v152
    v_and_b32 v113, s45, v152
    v_and_b32 v114, s46, v152
    v_and_b32 v115, s47, v152
    v_and_or_b32 v112, v153, s76, v112
    v_and_or_b32 v113, v153, s77, v113
    v_and_or_b32 v114, v153, s78, v114
    v_and_or_b32 v115, v153, s79, v115
    v_mfma_f32_16x16x32_bf16 v[144:147], v[116:119], v[24:27], v[144:147]
    v_mfma_f32_16x16x32_bf16 v[148:151], v[116:119], v[28:31], v[148:151]
    v_and_b32 v116, s48, v152
    v_and_b32 v117, s49, v152
    v_and_b32 v118, s50, v152
    v_and_b32 v119, s51, v152
    v_and_or_b32 v116, v153, s80, v116
    v_and_or_b32 v117, v153, s81, v117
    v_and_or_b32 v118, v153, s82, v118
    v_and_or_b32 v119, v153, s83, v119
    v_mfma_f32_16x16x32_bf16 v[144:147], v[112:115], v[32:35], v[144:147]
    v_mfma_f32_16x16x32_bf16 v[148:151], v[112:115], v[36:39], v[148:151]
    s_waitcnt vmcnt(12)
    ds_read_b64_tr_b16 v[56:57], v4 offset:10240
    ds_read_b64_tr_b16 v[58:59], v3 offset:10240
    ds_read_b64_tr_b16 v[60:61], v4 offset:11264
    ds_read_b64_tr_b16 v[62:63], v3 offset:11264
    v_and_b32 v112, s52, v152
    v_and_b32 v113, s53, v152
    v_and_b32 v114, s54, v152
    v_and_b32 v115, s55, v152
    v_and_or_b32 v112, v153, s84, v112
    v_and_or_b32 v113, v153, s85, v113
    v_and_or_b32 v114, v153, s86, v114
    v_and_or_b32 v115, v153, s87, v115
    v_mfma_f32_16x16x32_bf16 v[144:147], v[116:119], v[40:43], v[144:147]
    v_mfma_f32_16x16x32_bf16 v[148:151], v[116:119], v[44:47], v[148:151]
    s_waitcnt vmcnt(10)
    ds_read_b64_tr_b16 v[64:65], v4 offset:12288
    ds_read_b64_tr_b16 v[66:67], v3 offset:12288
    ds_read_b64_tr_b16 v[68:69], v4 offset:13312
    ds_read_b64_tr_b16 v[70:71], v3 offset:13312
    v_and_b32 v116, s56, v152
    v_and_b32 v117, s57, v152
    v_and_b32 v118, s58, v152
    v_and_b32 v119, s59, v152
    v_and_or_b32 v116, v153, s88, v116
    v_and_or_b32 v117, v153, s89, v117
    v_and_or_b32 v118, v153, s90, v118
    v_and_or_b32 v119, v153, s91, v119
    v_mfma_f32_16x16x32_bf16 v[144:147], v[112:115], v[48:51], v[144:147]
    v_mfma_f32_16x16x32_bf16 v[148:151], v[112:115], v[52:55], v[148:151]
    s_waitcnt vmcnt(8)
    ds_read_b64_tr_b16 v[72:73], v4 offset:14336
    ds_read_b64_tr_b16 v[74:75], v3 offset:14336
    ds_read_b64_tr_b16 v[76:77], v4 offset:15360
    ds_read_b64_tr_b16 v[78:79], v3 offset:15360
    v_and_b32 v112, s60, v152
    v_and_b32 v113, s61, v152
    v_and_b32 v114, s62, v152
    v_and_b32 v115, s63, v152
    v_and_or_b32 v112, v153, s92, v112
    v_and_or_b32 v113, v153, s93, v113
    v_and_or_b32 v114, v153, s94, v114
    v_and_or_b32 v115, v153, s95, v115
    s_waitcnt lgkmcnt(8)
    v_mfma_f32_16x16x32_bf16 v[144:147], v[116:119], v[56:59], v[144:147]
    v_mfma_f32_16x16x32_bf16 v[148:151], v[116:119], v[60:63], v[148:151]
    v_and_b32 v116, s64, v152
    v_and_b32 v117, s65, v152
    v_and_b32 v118, s66, v152
    v_and_b32 v119, s67, v152
    v_and_or_b32 v116, v153, s96, v116
    v_and_or_b32 v117, v153, s97, v117
    v_and_or_b32 v118, v153, s98, v118
    v_and_or_b32 v119, v153, s99, v119
    s_waitcnt lgkmcnt(4)
    v_mfma_f32_16x16x32_bf16 v[144:147], v[112:115], v[64:67], v[144:147]
    v_mfma_f32_16x16x32_bf16 v[148:151], v[112:115], v[68:71], v[148:151]
    s_waitcnt lgkmcnt(0)
    v_mfma_f32_16x16x32_bf16 v[144:147], v[116:119], v[72:75], v[144:147]
    v_mfma_f32_16x16x32_bf16 v[148:151], v[116:119], v[76:79], v[148:151]
    s_mov_b32 s36, 0x07060500
    s_mov_b32 s37, 0x07060501
    s_mov_b32 s38, 0x07060502
    s_mov_b32 s39, 0x07060503
    s_and_b32 s48, s22, 0xff
    s_bfe_u32 s49, s22, 0x80008
    s_bfe_u32 s50, s22, 0x80010
    s_lshr_b32 s51, s22, 24
    ds_write2_b64 v164, v[144:145], v[148:149] offset0:0 offset1:1
    s_waitcnt lgkmcnt(0)
    s_barrier
    ds_read_b128 v[20:23], v165
    s_mov_b32 s34, 65536
    s_or_b32 s24, s32, s33
    s_waitcnt lgkmcnt(0)
    v_permlane32_swap_b32 v20, v21
    v_permlane32_swap_b32 v22, v23
    v_add_f32 v20, v20, v21
    v_add_f32 v22, v22, v23
    s_cmp_eq_u32 s24, 0
    s_nop 0
    v_permlane16_swap_b32 v20, v22
    v_add_f32 v162, v20, v22
    s_cbranch_scc0 L_role
    global_store_dwordx2 v156, v[162:163], s[18:19]
L_pollh:
    global_load_dwordx4 v[20:23], v157, s[18:19] offset:-4096 sc1
    global_load_dwordx4 v[24:27], v157, s[18:19] sc1
    s_sub_u32 s34, s34, 1
    s_cbranch_scc1 L_end
    s_waitcnt vmcnt(1)
    v_bitop3_b32 v36, v21, v23, v12 bitop3:0x7e
    s_waitcnt vmcnt(0)
    v_bitop3_b32 v37, v25, v27, v12 bitop3:0x7e
    v_add_f32 v20, v20, v24
    v_or_b32 v36, v36, v37
    v_add_f32 v22, v22, v26
    v_cmp_ne_u32 vcc, 0, v36
    s_cbranch_vccnz L_pollh
    v_add_f32_dpp v26, v20, v20 row_shl:4 row_mask:0xf bank_mask:0x5
    v_add_f32_dpp v27, v22, v22 row_shl:4 row_mask:0xf bank_mask:0x5
    v_add_f32_dpp v26, v20, v20 row_shr:4 row_mask:0xf bank_mask:0xa
    v_add_f32_dpp v27, v22, v22 row_shr:4 row_mask:0xf bank_mask:0xa
    v_cvt_pk_bf16_f32 v28, v26, v27
    v_lshlrev_b32 v29, 16, v28
    v_mul_f32 v30, 0xbfb8aa3b, v29
    v_exp_f32 v30, v30
    v_and_b32 v28, 0xffff0000, v28
    v_add_f32 v30, 1.0, v30
    v_rcp_f32 v30, v30
    s_nop 0
    v_mul_f32 v30, v29, v30
    v_cvt_pk_bf16_f32 v30, v30, v30
    v_and_b32 v30, 0xffff0000, v30
    v_mul_f32 v30, v30, v28
    v_cvt_pk_bf16_f32 v30, v30, v30
    s_nop 1
    v_and_b32_dpp v112, v30, v8 quad_perm:[0,0,0,0] row_mask:0xf bank_mask:0xf
    v_and_b32_dpp v113, v30, v9 quad_perm:[0,0,0,0] row_mask:0xf bank_mask:0xf
    v_and_b32_dpp v114, v30, v10 quad_perm:[0,0,0,0] row_mask:0xf bank_mask:0xf
    v_and_b32_dpp v115, v30, v11 quad_perm:[0,0,0,0] row_mask:0xf bank_mask:0xf
    v_and_b32_dpp v116, v30, v8 quad_perm:[1,1,1,1] row_mask:0xf bank_mask:0xf
    v_and_b32_dpp v117, v30, v9 quad_perm:[1,1,1,1] row_mask:0xf bank_mask:0xf
    v_and_b32_dpp v118, v30, v10 quad_perm:[1,1,1,1] row_mask:0xf bank_mask:0xf
    v_and_b32_dpp v119, v30, v11 quad_perm:[1,1,1,1] row_mask:0xf bank_mask:0xf
    v_mfma_f32_16x16x32_bf16 v[144:147], v[112:115], v[80:83], 0
    v_mfma_f32_16x16x32_bf16 v[148:151], v[112:115], v[84:87], 0
    v_and_b32_dpp v120, v30, v8 quad_perm:[2,2,2,2] row_mask:0xf bank_mask:0xf
    v_and_b32_dpp v121, v30, v9 quad_perm:[2,2,2,2] row_mask:0xf bank_mask:0xf
    v_and_b32_dpp v122, v30, v10 quad_perm:[2,2,2,2] row_mask:0xf bank_mask:0xf
    v_and_b32_dpp v123, v30, v11 quad_perm:[2,2,2,2] row_mask:0xf bank_mask:0xf
    v_mfma_f32_16x16x32_bf16 v[144:147], v[116:119], v[88:91], v[144:147]
    v_mfma_f32_16x16x32_bf16 v[148:151], v[116:119], v[92:95], v[148:151]
    v_and_b32_dpp v124, v30, v8 quad_perm:[3,3,3,3] row_mask:0xf bank_mask:0xf
    v_and_b32_dpp v125, v30, v9 quad_perm:[3,3,3,3] row_mask:0xf bank_mask:0xf
    v_and_b32_dpp v126, v30, v10 quad_perm:[3,3,3,3] row_mask:0xf bank_mask:0xf
    v_and_b32_dpp v127, v30, v11 quad_perm:[3,3,3,3] row_mask:0xf bank_mask:0xf
    v_mfma_f32_16x16x32_bf16 v[144:147], v[120:123], v[96:99], v[144:147]
    v_mfma_f32_16x16x32_bf16 v[148:151], v[120:123], v[100:103], v[148:151]
    v_mfma_f32_16x16x32_bf16 v[144:147], v[124:127], v[104:107], v[144:147]
    v_mfma_f32_16x16x32_bf16 v[148:151], v[124:127], v[108:111], v[148:151]
    v_mov_b32 v40, v154
    v_add_u32 v41, 131072, v40
    v_add_u32 v42, 131072, v41
    v_add_u32 v43, 131072, v42
    v_mov_b32 v60, s48
    v_mov_b32 v61, s49
    v_mov_b32 v62, s50
    ds_write_b128 v5, v[144:147]
    ds_write_b128 v5, v[148:151] offset:1024
    v_mov_b32 v63, s51
    s_mov_b32 s44, 4294967295
    s_mov_b32 s45, 0
    s_waitcnt lgkmcnt(0)
    s_barrier
    ds_read_b128 v[116:119], v6
    ds_read_b128 v[20:23], v6 offset:2048
    ds_read_b128 v[24:27], v6 offset:4096
    ds_read_b128 v[28:31], v6 offset:6144
    s_mov_b32 exec_hi, 0
    s_cmp_ge_u32 s23, 128
    s_waitcnt lgkmcnt(2)
    v_pk_add_f32 v[116:117], v[116:117], v[20:21]
    v_pk_add_f32 v[118:119], v[118:119], v[22:23]
    s_waitcnt lgkmcnt(0)
    v_pk_add_f32 v[24:25], v[24:25], v[28:29]
    v_pk_add_f32 v[26:27], v[26:27], v[30:31]
    v_pk_add_f32 v[116:117], v[116:117], v[24:25]
    v_pk_add_f32 v[118:119], v[118:119], v[26:27]
    v_perm_b32 v116, v116, v12, s36
    v_perm_b32 v117, v117, v12, s37
    v_perm_b32 v118, v118, v12, s38
    v_perm_b32 v119, v119, v12, s39
    global_store_dwordx4 v7, v[116:119], s[18:19] sc1
    s_cbranch_scc1 L_wdone
    s_mov_b64 exec, -1
    global_load_ushort v160, v155, s[4:5]
    s_and_b32 s28, s28, 0xffff0000
    s_ashr_i32 s30, s28, 31
    s_not_b32 s30, s30
    s_or_b32 s30, s30, 0x80000000
    s_xor_b32 s28, s28, s30
    s_and_b32 s28, s28, 0xffff0000
    v_mov_b32 v161, 0xbfb8aa3b
    v_mul_f32 v161, s28, v161
    v_exp_f32 v161, v161
    s_mov_b32 s34, 65536
    v_add_f32 v161, 1.0, v161
    v_rcp_f32 v161, v161
    s_nop 0
    v_cvt_pk_bf16_f32 v161, v161, v161
    v_and_b32 v161, 0xffff0000, v161
    s_waitcnt vmcnt(1)
    s_sleep 8
L_poll2:
    global_load_dwordx4 v[48:51], v40, s[18:19] sc1
    global_load_dwordx4 v[52:55], v41, s[18:19] sc1
    global_load_dwordx4 v[56:59], v42, s[18:19] sc1
    s_mov_b64 exec, s[44:45]
    global_load_dwordx4 v[60:63], v43, s[18:19] sc1
    s_mov_b64 exec, -1
    s_sub_u32 s34, s34, 1
    s_cbranch_scc1 L_end
    s_waitcnt vmcnt(3)
    v_xor_b32 v32, s48, v48
    v_xor_b32 v33, s49, v49
    v_xor_b32 v34, s50, v50
    v_xor_b32 v35, s51, v51
    v_or3_b32 v4, v32, v33, v34
    v_or_b32 v4, v4, v35
    s_waitcnt vmcnt(2)
    v_xor_b32 v36, s48, v52
    v_xor_b32 v37, s49, v53
    v_xor_b32 v38, s50, v54
    v_xor_b32 v39, s51, v55
    v_or3_b32 v4, v4, v36, v37
    v_or3_b32 v4, v4, v38, v39
    v_pk_add_f32 v[32:33], v[32:33], v[36:37]
    v_pk_add_f32 v[34:35], v[34:35], v[38:39]
    s_waitcnt vmcnt(1)
    v_xor_b32 v36, s48, v56
    v_xor_b32 v37, s49, v57
    v_xor_b32 v38, s50, v58
    v_xor_b32 v39, s51, v59
    v_or3_b32 v4, v4, v36, v37
    v_or3_b32 v4, v4, v38, v39
    v_pk_add_f32 v[32:33], v[32:33], v[36:37]
    v_pk_add_f32 v[34:35], v[34:35], v[38:39]
    s_waitcnt vmcnt(0)
    v_xor_b32 v36, s48, v60
    v_xor_b32 v37, s49, v61
    v_xor_b32 v38, s50, v62
    v_xor_b32 v39, s51, v63
    v_or3_b32 v4, v4, v36, v37
    v_or3_b32 v4, v4, v38, v39
    v_pk_add_f32 v[32:33], v[32:33], v[36:37]
    v_pk_add_f32 v[34:35], v[34:35], v[38:39]
    v_and_b32 v4, 0xff, v4
    v_cmp_ne_u32 vcc, 0, v4
    s_cbranch_vccnz L_poll2
    v_permlane32_swap_b32 v32, v33
    v_permlane32_swap_b32 v34, v35
    v_add_f32 v32, v32, v33
    v_add_f32 v34, v34, v35
    v_lshlrev_b32 v160, 16, v160
    s_mov_b32 s44, 983055
    v_permlane16_swap_b32 v32, v34
    v_add_f32 v4, v32, v34
    v_mul_f32 v5, 0, v160
    s_mov_b32 s45, s44
    v_add_f32_dpp v4, v4, v4 row_ror:8 row_mask:0xf bank_mask:0xf
    s_nop 1
    v_add_f32_dpp v4, v4, v4 row_ror:4 row_mask:0xf bank_mask:0xf
    v_cvt_pk_bf16_f32 v4, v4, v4
    v_and_b32 v4, 0xffff0000, v4
    v_mul_f32 v4, v4, v161
    v_cvt_pk_bf16_f32 v4, v4, v4
    v_and_b32 v4, 0xffff0000, v4
    v_add_f32 v4, v4, v5
    v_add_f32 v4, v4, v160
    v_cvt_pk_bf16_f32 v4, v4, v4
    s_mov_b64 exec, s[44:45]
    global_store_short v155, v4, s[14:15]
    s_cmp_lg_u32 s23, 0
    s_cbranch_scc1 L_wfin
    s_mov_b64 exec, 1
    v_mov_b32 v5, 0
    global_store_dword v5, v166, s[18:19]
L_wfin:
L_wdone:
L_end:
    s_endpgm
L_mfr:
    s_sleep 2
    s_branch L_mfast
L_mslow:
    s_mov_b32 s24, 65536
L_mslow1:
    s_load_dwordx4 s[28:31], s[18:19], s3 glc
    s_sub_u32 s24, s24, 1
    s_cbranch_scc1 L_end
    s_waitcnt lgkmcnt(0)
    s_cmp_eq_u32 s29, s22
    s_cbranch_scc0 L_mslow1
    s_xor_b32 s33, s31, s22
    s_cmp_le_u32 s33, 3
    s_cbranch_scc0 L_mslow1
    s_branch L_mgot
L_role:
    s_cmp_eq_u32 s33, 0
    s_cbranch_scc0 L_hslow
    global_store_dwordx2 v156, v[162:163], s[18:19]
    s_branch L_wdone
L_hslow:
    v_add_u32 v156, 2097152, v156
    v_add_u32 v157, 2097152, v157
    global_store_dwordx2 v156, v[162:163], s[18:19] sc1
    s_cmp_eq_u32 s32, 0
    s_cbranch_scc0 L_wdone
    s_waitcnt vmcnt(0)
    s_branch L_pollh
L_c3:
    s_mov_b64 exec, 1
    global_load_dword v80, v156, s[18:19]
    global_load_dword v80, v156, s[18:19]
    global_load_dword v80, v156, s[18:19]
    global_load_dword v80, v156, s[18:19]
    global_load_dword v80, v156, s[18:19]
    global_load_dword v80, v156, s[18:19]
    global_load_dword v80, v156, s[18:19]
    global_load_dword v80, v156, s[18:19]
    s_mov_b64 exec, -1
    s_branch L_wdj
L_help:
    s_cmp_eq_u32 s23, 4
    s_cbranch_scc1 L_h4x
    s_sub_u32 s28, s24, 4
    s_max_i32 s28, s28, 0
    s_mul_i32 s30, s28, 86
    s_lshr_b32 s30, s30, 8
    s_mul_i32 s31, s30, 3
    s_sub_u32 s31, s28, s31
    s_lshl_b32 s30, s30, 5
    s_add_u32 s30, s30, s31
    s_add_u32 s30, s30, 5
    s_mul_i32 s30, s30, 57344
    v_add_u32 v1, s30, v16
    s_waitcnt lgkmcnt(0)
    s_load_dword s22, s[18:19], 0
    v_lshlrev_b32 v7, 5, v14
    v_lshl_add_u32 v7, v15, 4, v7
    s_lshl_b32 s27, s25, 13
    s_and_b32 s29, s21, 1
    s_lshl_b32 s29, s29, 12
    s_add_u32 s27, s27, s29
    s_lshl_b32 s29, s26, 10
    s_add_u32 s27, s27, s29
    s_lshr_b32 s29, s21, 1
    s_lshl_b32 s29, s29, 9
    s_add_u32 s27, s27, s29
    s_add_u32 s27, s27, 1572864
    v_add_u32 v7, s27, v7
    s_add_u32 s48, s18, s27
    s_addc_u32 s49, s19, 0
    v_lshlrev_b32 v2, 13, v13
    v_lshl_add_u32 v2, v14, 4, v2
    s_lshl_b32 s27, s25, 17
    s_lshl_b32 s29, s21, 15
    s_add_u32 s27, s27, s29
    s_lshl_b32 s29, s26, 9
    s_add_u32 s27, s27, s29
    s_add_u32 s27, s27, 4096
    v_add_u32 v2, s27, v2
    s_getreg_b32 s33, hwreg(HW_REG_XCC_ID, 0, 3)
    s_lshl_b32 s33, s33, 13
    s_getreg_b32 s34, hwreg(HW_REG_HW_ID, 8, 1)
    s_lshl_b32 s34, s34, 2
    s_add_u32 s34, s34, s21
    s_mul_i32 s34, s34, 960
    s_add_u32 s34, s34, s33
    s_add_u32 s34, s34, 131072
    s_lshl_b32 s3, s2, 7
    s_add_u32 s3, s3, 65536
    v_bfe_u32 v5, v0, 2, 1
    v_lshlrev_b32 v157, 11, v5
    v_lshl_add_u32 v157, v13, 7, v157
    v_and_b32 v6, 3, v0
    v_lshl_add_u32 v157, v6, 5, v157
    v_bfe_u32 v5, v0, 3, 1
    v_lshl_add_u32 v157, v5, 4, v157
    s_lshl_b32 s27, s25, 13
    s_lshl_b32 s30, s21, 9
    s_add_u32 s27, s27, s30
    s_add_u32 s27, s27, 1052672
    v_add_u32 v157, s27, v157
    s_lshl_b32 s27, s21, 11
    s_add_u32 s27, s27, 65536
    v_lshl_add_u32 v5, v0, 4, s27
    v_and_b32 v6, 31, v0
    s_lshl_b32 s27, s21, 9
    s_add_u32 s27, s27, 65536
    v_lshl_add_u32 v6, v6, 4, s27
    v_and_b32 v8, 1, v0
    v_lshlrev_b32 v8, 4, v8
    v_mov_b32 v9, 0xffff
    v_lshlrev_b32 v12, v8, v9
    v_bfe_u32 v159, v0, 1, 2
    v_cmp_eq_u32 vcc, 0, v159
    s_nop 1
    v_cndmask_b32 v8, 0, v12, vcc
    v_cmp_eq_u32 vcc, 1, v159
    s_nop 1
    v_cndmask_b32 v9, 0, v12, vcc
    v_cmp_eq_u32 vcc, 2, v159
    s_nop 1
    v_cndmask_b32 v10, 0, v12, vcc
    v_cmp_eq_u32 vcc, 3, v159
    s_nop 1
    v_cndmask_b32 v11, 0, v12, vcc
    s_getreg_b32 s33, hwreg(HW_REG_XCC_ID, 0, 3)
    s_lshl_b32 s33, s33, 13
    s_add_u32 s33, s33, 131072
    v_lshl_add_u32 v3, v0, 6, s33
    v_add_u32 v4, 4096, v3
    s_barrier
    s_cmp_eq_u32 s24, 14
    s_cbranch_scc0 L_h2
    global_load_dword v113, v3, s[18:19]
    global_load_dword v114, v4, s[18:19]
L_h2:
    s_cmp_lt_u32 s24, 4
    s_cbranch_scc1 L_h4
    s_mov_b32 exec_lo, 0x00ff00ff
    s_mov_b32 exec_hi, 0x00ff00ff
    global_load_dword v120, v1, s[8:9]
    s_not_b64 exec, exec
    global_load_dword v120, v1, s[10:11]
    s_mov_b64 exec, -1
    global_load_dwordx4 v[80:83], v2, s[12:13] offset:-4096 nt
    global_load_dwordx4 v[84:87], v2, s[12:13] offset:-3840 nt
    global_load_dwordx4 v[88:91], v2, s[12:13] offset:-2048 nt
    global_load_dwordx4 v[92:95], v2, s[12:13] offset:-1792 nt
    global_load_dwordx4 v[96:99], v2, s[12:13] offset:0 nt
    global_load_dwordx4 v[100:103], v2, s[12:13] offset:256 nt
    global_load_dwordx4 v[104:107], v2, s[12:13] offset:2048 nt
    global_load_dwordx4 v[108:111], v2, s[12:13] offset:2304 nt
L_h4:
    s_mov_b32 s23, 0x1000
    v_mov_b32 v154, 0
    v_mov_b32 v155, 0
    s_waitcnt lgkmcnt(0)
    s_add_u32 s22, s22, 2654435769
    v_mov_b32 v166, s22
    s_or_b32 s22, s22, 1
    v_mov_b32 v12, s22
    v_mov_b32 v163, s22
    s_mov_b32 s36, 0x07060500
    s_mov_b32 s37, 0x07060501
    s_mov_b32 s38, 0x07060502
    s_mov_b32 s39, 0x07060503
    s_and_b32 s48, s22, 0xff
    s_bfe_u32 s49, s22, 0x80008
    s_bfe_u32 s50, s22, 0x80010
    s_lshr_b32 s51, s22, 24
    s_cmp_ge_u32 s24, 4
    s_cbranch_scc1 L_h6
    s_barrier
    global_load_dwordx4 v[80:83], v2, s[12:13] offset:-4096 nt
    global_load_dwordx4 v[84:87], v2, s[12:13] offset:-3840 nt
    global_load_dwordx4 v[88:91], v2, s[12:13] offset:-2048 nt
    global_load_dwordx4 v[92:95], v2, s[12:13] offset:-1792 nt
    global_load_dwordx4 v[96:99], v2, s[12:13] offset:0 nt
    global_load_dwordx4 v[100:103], v2, s[12:13] offset:256 nt
    global_load_dwordx4 v[104:107], v2, s[12:13] offset:2048 nt
    global_load_dwordx4 v[108:111], v2, s[12:13] offset:2304 nt
    s_branch L_h7
L_h6:
    s_waitcnt vmcnt(0)
    s_sleep 8
L_h7:
    s_mov_b32 s27, 15
L_hm:
    s_sub_u32 s27, s27, 1
    s_cbranch_scc1 L_hmslow
    s_load_dwordx4 s[28:31], s[18:19], s34
    s_add_u32 s34, s34, 64
    s_waitcnt lgkmcnt(0)
    s_xor_b32 s33, s31, s22
    s_cmp_le_u32 s33, 3
    s_cbranch_scc1 L_hgot
    s_sleep 4
    s_branch L_hm
L_hmslow:
    s_mov_b32 s27, 65536
L_hmslow1:
    s_load_dwordx4 s[28:31], s[18:19], s3 glc
    s_sub_u32 s27, s27, 1
    s_cbranch_scc1 L_end
    s_waitcnt lgkmcnt(0)
    s_xor_b32 s33, s31, s22
    s_cmp_le_u32 s33, 3
    s_cbranch_scc0 L_hmslow1
L_hgot:
L_h5:
    s_mov_b32 s34, 65536
    s_cmp_eq_u32 s33, 0
    s_cbranch_scc1 L_pollh
    v_add_u32 v157, 2097152, v157
    s_branch L_pollh
L_h4x:
    s_cmp_eq_u32 s24, 14
    s_cbranch_scc0 L_end
    s_getreg_b32 s33, hwreg(HW_REG_XCC_ID, 0, 3)
    s_lshl_b32 s33, s33, 13
    s_add_u32 s33, s33, 131072
    v_lshl_add_u32 v3, v0, 6, s33
    v_add_u32 v4, 4096, v3
    s_waitcnt lgkmcnt(0)
    s_barrier
    global_load_dword v113, v3, s[18:19]
    global_load_dword v114, v4, s[18:19]
    s_endpgm
L_codeend:
.section .rodata,"a"
.p2align 6
.amdhsa_kernel standalone__moe_arch_mod__prompt_kernel
  .amdhsa_next_free_vgpr 168
  .amdhsa_next_free_sgpr 102
  .amdhsa_accum_offset 168
  .amdhsa_group_segment_fixed_size 0
  .amdhsa_kernarg_size 64
  .amdhsa_user_sgpr_count 2
  .amdhsa_user_sgpr_kernarg_segment_ptr 1
  .amdhsa_system_sgpr_workgroup_id_x 1
  .amdhsa_float_denorm_mode_32 3
.end_amdhsa_kernel
```
